```python
import torch

def _softmax(x, axis=-1):
    return torch.softmax(x, dim=axis)
def _gelu(x):
    return torch.nn.functional.gelu(x, approximate="tanh")
def _silu(x):
    return torch.nn.functional.silu(x)
def _sigmoid(x):
    return torch.sigmoid(x)
def _layernorm(x, axis=-1, eps=1e-5):
    m = x.mean(dim=axis, keepdim=True)
    v = x.var(dim=axis, keepdim=True, unbiased=False)
    return (x - m) / torch.sqrt(v + eps)
def _scatter_add(tgt, idx, src, axis=0):
    return tgt.clone().index_add_(axis, idx, src)
def _segment_sum(src, seg, n):
    out = torch.zeros((n,) + src.shape[1:], dtype=src.dtype)
    return out.index_add_(0, seg, src)
def _pad(x, pw):
    flat = tuple(v for pair in reversed(pw) for v in pair)
    return torch.nn.functional.pad(x, flat)

kernel_name = 'standalone__glu_gated_geglu__sampling'

def setup_inputs():

    _w = (lambda a: (lambda t: t.to(torch.bfloat16) if t.is_floating_point() else t)(torch.as_tensor(a)))
    B, S, Dm, Df = 8, 4, 1024, 3584
    return {
        "x": _w((lambda *s: torch.randn(*s, dtype=torch.bfloat16) * 0.05)(B, S, Dm)),
        "w_gate": _w((lambda *s: torch.randn(*s, dtype=torch.bfloat16) * 0.05)(Dm, Df) * (Dm ** -0.5)),
        "w_up": _w((lambda *s: torch.randn(*s, dtype=torch.bfloat16) * 0.05)(Dm, Df) * (Dm ** -0.5)),
        "w_down": _w((lambda *s: torch.randn(*s, dtype=torch.bfloat16) * 0.05)(Df, Dm) * (Df ** -0.5)),
    }

def reference(x, w_gate, w_up, w_down):
    g = torch.einsum("bsd,df->bsf", x, w_gate)
    u = torch.einsum("bsd,df->bsf", x, w_up)
    h = _gelu(g) * u
    return torch.einsum("bsf,fd->bsd", h, w_down)
```

```asm
; @launch grid=(256,1,1) block=(512,1,1) lds=147456
.amdgcn_target "amdgcn-amd-amdhsa--gfx950"
.text
.globl standalone__glu_gated_geglu__sampling_kernel
.p2align 8
.type standalone__glu_gated_geglu__sampling_kernel,@function
standalone__glu_gated_geglu__sampling_kernel:

    s_load_dwordx8 s[4:11], s[0:1], 0
    s_load_dwordx4 s[12:15], s[0:1], 32
    s_load_dwordx2 s[16:17], s[0:1], 48
    s_cmp_ge_u32 s2, 256
    s_cbranch_scc1 L_end
    v_readfirstlane_b32 s18, v0
    v_and_b32 v1, 63, v0
    s_and_b32 s19, s2, 7
    s_lshr_b32 s20, s2, 3
    s_lshr_b32 s99, s18, 8
    s_bfe_u32 s18, s18, 0x20006
    s_cmp_lt_u32 s20, 24
    s_cselect_b32 s3, s99, 0
    s_cmp_lg_u32 s3, 0
    s_cbranch_scc0 L_go
    s_endpgm
L_go:
    s_add_u32 s24, s19, 3
    s_and_b32 s24, s24, 7
    s_cmp_eq_u32 s24, 7
    s_cselect_b32 s24, 0, s24
    s_and_b32 s25, s20, 1
    s_bfe_u32 s26, s20, 0x10001
    s_lshl_b32 s27, s26, 9
    s_lshr_b32 s28, s20, 2
    s_cmp_ge_u32 s28, s24
    s_addc_u32 s28, s28, 0
    s_bfe_u32 s3, s20, 0x20001
    s_lshl_b32 s29, s3, 8
    s_cmp_ge_u32 s20, 24
    s_cselect_b32 s26, s3, s26
    s_cselect_b32 s27, s29, s27
    s_cselect_b32 s28, s24, s28
    v_lshrrev_b32 v5, 3, v1
    v_mul_u32_u24 v2, 7168, v5
    v_bfe_u32 v3, v1, 1, 2
    v_bfe_u32 v4, v1, 4, 1
    s_and_b32 s35, s18, 1
    s_lshl_b32 s29, s35, 1
    v_xor_b32 v3, v3, v4
    v_xor_b32 v3, s29, v3
    v_lshlrev_b32 v3, 5, v3
    v_and_b32 v4, 1, v1
    v_lshl_add_u32 v6, v4, 4, v3
    v_add_u32 v2, v2, v6
    v_add_u32 v3, 228352, v2
    s_lshl_b32 s3, s18, 3
    s_add_u32 s3, s3, s27
    s_mul_i32 s3, s3, 7168
    s_mul_i32 s29, s19, 896
    s_add_u32 s3, s3, s29
    s_lshl_b32 s29, s28, 7
    s_add_u32 s3, s3, s29
    s_mul_i32 s61, s18, 3072
    s_mov_b32 m0, s61
    s_getreg_b32 s34, hwreg(HW_REG_XCC_ID)
    s_and_b32 s34, s34, 15
    s_or_b32 s34, s34, 0x80
    s_lshl_b32 s33, s19, 5
    s_add_u32 s29, s33, s20
    v_mov_b32 v10, s29
    v_mov_b32 v11, s34
    s_mov_b32 s63, 458752
    s_cmp_eq_u32 s25, 1
    s_mov_b64 exec, 1
    s_waitcnt lgkmcnt(0)
    global_store_byte v10, v11, s[14:15]
    s_mov_b64 exec, -1
    s_cselect_b32 s6, s8, s6
    s_cselect_b32 s7, s9, s7
    s_add_u32 s6, s6, s3
    s_addc_u32 s7, s7, 0
    s_load_dword s21, s[16:17], 12
    s_cmp_ge_u32 s20, 24

    s_mov_b32 s62, 3
    s_cbranch_scc0 L_dma
    s_cmp_lg_u32 s99, 0
    s_cbranch_scc1 L_early
    s_getpc_b64 s[30:31]
L_pc:
    s_sub_u32 s30, s30, L_pc - standalone__glu_gated_geglu__sampling_kernel
    s_subb_u32 s31, s31, 0
    s_lshl_b32 s29, s20, 2
    s_add_u32 s29, s29, s18
    s_and_b32 s29, s29, 31
    s_lshl_b32 s3, s29, 8
    v_lshl_add_u32 v13, v1, 7, s3
    s_lshl_b32 s3, s29, 11
    v_lshl_add_u32 v14, v1, 7, s3

    s_mov_b64 exec, 0xffff
    global_load_dword v79, v14, s[4:5]
    s_mov_b64 exec, 3
    global_load_dword v79, v13, s[30:31]
    global_load_ubyte v79, v10, s[14:15] sc1
    s_mov_b64 exec, -1
    s_mov_b32 s62, 4
L_dma:
    global_load_lds_dwordx4 v2, s[6:7] nt
    global_load_lds_dwordx4 v3, s[6:7] offset:1024 nt
    s_add_u32 m0, m0, 12288
    s_add_u32 s6, s6, s63
    s_addc_u32 s7, s7, 0
    s_sub_u32 s62, s62, 1
    s_cmp_lg_u32 s62, 0
    s_cbranch_scc1 L_dma

L_early:

    s_lshl_b32 s29, s35, 2
    v_lshrrev_b32 v8, 4, v1
    v_or_b32 v4, s29, v8
    v_and_b32 v7, 7, v1
    v_xor_b32 v4, v4, v7
    v_lshlrev_b32 v4, 4, v4
    v_lshl_add_u32 v15, v5, 11, v4
    s_lshl_b32 s35, s18, 14
    s_lshl_b32 s29, s27, 1
    s_add_u32 s35, s35, s29
    s_sub_u32 s35, s35, 2048
    s_ashr_i32 s29, s35, 31
    s_add_u32 s4, s4, s35
    s_addc_u32 s5, s5, s29
    s_lshl_b32 s60, s19, 2
    s_add_u32 s60, s60, s26
    s_lshl_b32 s60, s60, 1
    s_add_u32 s60, s60, s25
    s_mul_i32 s60, s60, 57344
    s_lshl_b32 s29, s28, 13
    s_add_u32 s60, s60, s29
    s_lshl_b32 s29, s18, 11
    s_add_u32 s60, s60, s29
    s_add_u32 s60, s60, 4194304
    v_lshl_add_u32 v62, v1, 7, s60
    s_mov_b32 s90, 0xffff

    s_cmp_ge_u32 s20, 24
    s_cbranch_scc1 L_L

    s_lshl_b32 s29, s19, 3
    s_lshr_b32 s3, s20, 1
    s_add_u32 s29, s29, s3
    s_mul_i32 s29, s29, 57344
    s_lshl_b32 s3, s24, 13
    s_add_u32 s29, s29, s3
    s_lshl_b32 s3, s25, 12
    s_add_u32 s29, s29, s3
    s_lshl_b32 s3, s18, 10
    s_add_u32 s29, s29, s3
    s_add_u32 s29, s29, 4192256
    v_lshl_add_u32 v13, v1, 7, s29
    v_cmp_lt_u32 vcc, 15, v1
    s_cmp_lt_u32 s20, 16
    s_cselect_b32 s90, 0xffffff, s90
    v_cndmask_b32 v62, v62, v13, vcc

    s_add_u32 m0, s61, 0
    s_nop 0
    global_load_lds_dwordx4 v15, s[4:5] offset:2048
    s_add_u32 m0, s61, 36864
    s_nop 0
    global_load_lds_dwordx4 v2, s[6:7] nt
    global_load_lds_dwordx4 v3, s[6:7] offset:1024 nt
    s_add_u32 s6, s6, s63
    s_addc_u32 s7, s7, 0
    s_add_u32 m0, s61, 12160
    s_nop 0
    global_load_lds_dwordx4 v15, s[4:5] offset:2176
    s_add_u32 m0, s61, 49152
    s_nop 0
    global_load_lds_dwordx4 v2, s[6:7] nt
    global_load_lds_dwordx4 v3, s[6:7] offset:1024 nt
    s_add_u32 s6, s6, s63
    s_addc_u32 s7, s7, 0
    s_add_u32 m0, s61, 24320
    s_nop 0
    global_load_lds_dwordx4 v15, s[4:5] offset:2304
    s_add_u32 m0, s61, 61440
    s_nop 0
    global_load_lds_dwordx4 v2, s[6:7] nt
    global_load_lds_dwordx4 v3, s[6:7] offset:1024 nt
    s_add_u32 s6, s6, s63
    s_addc_u32 s7, s7, 0
    s_add_u32 m0, s61, 36480
    s_nop 0
    global_load_lds_dwordx4 v15, s[4:5] offset:2432

    v_and_b32 v7, 15, v1
    v_lshlrev_b32 v9, 4, v7
    v_and_b32 v5, 31, v1
    v_add_u32 v78, s33, v5
    s_waitcnt lgkmcnt(0)
    s_lshr_b32 s23, s21, 16
    s_add_u32 s23, s23, 1
    s_cmp_gt_u32 s23, 0x7f00
    s_cselect_b32 s23, 1, s23
    s_lshl_b32 s23, s23, 16
    s_add_u32 s22, s21, 1
    s_and_b32 s22, s22, 0xff
    s_max_u32 s22, s22, 1
    s_add_u32 s98, s22, 1
    s_and_b32 s98, s98, 0xff
    s_max_u32 s98, s98, 1
    s_or_b32 s21, s23, s98
    s_lshl_b32 s97, s19, 2
    s_lshr_b32 s97, 0x76543210, s97
    s_and_b32 s97, s97, 7
    v_mov_b32 v10, 0xff
    v_lshl_add_u32 v77, v8, 9, v9
    v_add_u32 v77, s60, v77
    v_bfe_u32 v11, v1, 2, 2
    v_lshlrev_b32 v11, 7, v11
    v_and_b32 v60, 3, v1
    v_lshl_add_u32 v11, v60, 3, v11
    v_bfe_u32 v12, v1, 3, 2
    v_xor_b32 v60, s18, v12
    v_lshl_add_u32 v60, v60, 5, v11
    v_mul_u32_u24 v61, 3072, v8
    v_add_u32 v60, v60, v61
    v_add_u32 v61, 49152, v60
    v_lshrrev_b32 v4, 3, v7
    v_mul_u32_u24 v4, 3072, v4
    v_and_b32 v13, 7, v7
    v_lshl_add_u32 v4, v13, 7, v4
    v_lshrrev_b32 v13, 1, v7
    v_xor_b32 v13, v13, v8
    v_lshl_add_u32 v4, v13, 4, v4
    v_add_u32 v4, 2048, v4
    v_xor_b32 v5, 64, v4
    v_add_u32 v13, 49152, v4
    v_add_u32 v14, 49152, v5

    s_lshr_b32 s3, s20, 1
    s_mul_i32 s64, s3, 11
    s_sub_u32 s29, s3, 8
    s_max_i32 s29, s29, 0
    s_sub_u32 s64, s64, s29
    s_cmp_ge_u32 s3, 8
    s_cselect_b32 s65, 10, 11
    v_lshrrev_b32 v64, 3, v1
    s_mul_i32 s29, s18, 6
    v_add_u32 v65, s29, v64
    s_add_u32 s29, s18, 24
    v_mov_b32 v66, s29
    v_cmp_lt_u32 vcc, 5, v64
    s_mul_i32 s29, s64, 57344
    s_lshl_b32 s35, s97, 8
    v_cndmask_b32 v65, v65, v66, vcc
    v_lshl_add_u32 v65, v65, 11, v6
    s_add_u32 s29, s29, s35
    s_lshl_b32 s35, s25, 7
    s_add_u32 s29, s29, s35
    s_add_u32 s10, s10, s29
    s_addc_u32 s11, s11, 0
    s_lshr_b32 s66, s18, 1
    s_lshl_b32 s29, s66, 12
    s_add_u32 s29, s29, 98304
    v_lshl_add_u32 v66, v8, 10, v11
    v_lshl_add_u32 v66, v12, 5, v66
    v_add_u32 v66, s29, v66
    v_xor_b32 v67, 32, v66
    v_xor_b32 v68, 64, v66
    v_xor_b32 v69, 96, v66
    v_lshlrev_b32 v56, 12, v64
    v_and_b32 v57, 7, v1
    v_lshl_add_u32 v56, v57, 4, v56
    s_lshl_b32 s29, s18, 10
    s_add_u32 s29, s29, 99200
    v_add_u32 v56, s29, v56
    v_mov_b32 v200, 0
    v_mov_b32 v201, 0
    v_mov_b32 v202, 0
    v_mov_b32 v203, 0
    ds_write_b128 v56, v[200:203]
    s_mov_b32 exec_hi, 0
    ds_write_b128 v56, v[200:203] offset:32768
    s_mov_b32 exec_hi, -1
    s_add_u32 s67, s65, 1
    s_sub_u32 s67, s67, s66
    s_lshr_b32 s67, s67, 1
    s_and_b32 s3, s18, 1
    s_lshl_b32 s29, s3, 17
    s_add_u32 s35, s66, s64
    s_lshl_b32 s35, s35, 10
    s_add_u32 s29, s29, s35
    s_add_u32 s29, s29, 65536
    v_lshlrev_b32 v73, 4, v1
    v_add_u32 v70, s29, v73
    v_add_u32 v71, 4096, v70
    v_add_u32 v72, 8192, v70
    s_sub_u32 s35, s67, 1
    s_lshl_b32 s35, s35, 11
    v_add_u32 v57, s35, v70
    s_lshl_b32 s29, s18, 11
    s_sub_u32 s29, s60, s29
    s_lshl_b32 s3, s3, 12
    s_add_u32 s29, s29, s3
    s_lshl_b32 s3, s66, 11
    s_add_u32 s29, s29, s3
    v_add_u32 v74, s29, v73
    s_mul_i32 s3, s28, 293
    s_lshr_b32 s3, s3, 7
    s_add_u32 s3, s3, s18
    s_min_u32 s3, s3, 15
    s_lshl_b32 s3, s3, 10
    v_lshl_add_u32 v63, v1, 8, s3
    s_lshl_b32 s3, s19, 14
    s_add_u32 s3, s3, 65548
    v_mov_b32 v216, s23
    v_add_u32 v63, s3, v63
    s_lshl_b32 s3, s18, 11
    s_add_u32 s3, s3, 0
    v_add_u32 v75, s3, v73
    v_xor_b32 v76, 4096, v75

    s_lshl_b32 s92, s18, 10
    s_add_u32 s92, s92, 98304
    s_mov_b32 s93, 57344

    s_add_u32 m0, s61, 73728
    s_nop 0
    global_load_lds_dwordx4 v2, s[6:7] nt
    global_load_lds_dwordx4 v3, s[6:7] offset:1024 nt
    s_add_u32 s6, s6, s63
    s_addc_u32 s7, s7, 0
    s_add_u32 m0, s61, 48640
    s_nop 0
    global_load_lds_dwordx4 v15, s[4:5] offset:2560
    s_add_u32 m0, s61, 60800
    s_nop 0
    global_load_lds_dwordx4 v15, s[4:5] offset:2688
    s_add_u32 m0, s61, 86016
    s_nop 0
    global_load_lds_dwordx4 v2, s[6:7] nt
    global_load_lds_dwordx4 v3, s[6:7] offset:1024 nt
    s_add_u32 s6, s6, s63
    s_addc_u32 s7, s7, 0
    s_add_u32 m0, s61, 72960
    s_nop 0
    global_load_lds_dwordx4 v15, s[4:5] offset:2816
    s_add_u32 m0, s61, 85120
    s_nop 0
    global_load_lds_dwordx4 v15, s[4:5] offset:2944
    global_load_ubyte v78, v78, s[14:15] sc1
    s_mov_b32 exec_hi, 0
    s_mov_b32 exec_lo, s90
    global_load_dword v79, v62, s[16:17] sc1
    s_mov_b64 exec, -1
    s_waitcnt vmcnt(10)
    s_barrier
    ds_read_b64_tr_b16 v[80:81], v60 offset:0
    ds_read_b64_tr_b16 v[82:83], v60 offset:512
    ds_read_b128 v[24:27], v4 offset:0
    ds_read_b128 v[28:31], v4 offset:6144
    ds_read_b64_tr_b16 v[84:85], v60 offset:1024
    ds_read_b64_tr_b16 v[86:87], v60 offset:1536
    ds_read_b128 v[32:35], v5 offset:0
    ds_read_b128 v[36:39], v5 offset:6144
    ds_read_b64_tr_b16 v[88:89], v60 offset:12288
    ds_read_b64_tr_b16 v[90:91], v60 offset:12800
    ds_read_b128 v[40:43], v4 offset:12288
    ds_read_b128 v[44:47], v4 offset:18432
    s_waitcnt lgkmcnt(8)
    v_mfma_f32_16x16x32_bf16 v[16:19], v[80:83], v[24:27], 0
    v_mfma_f32_16x16x32_bf16 v[20:23], v[80:83], v[28:31], 0
    ds_read_b64_tr_b16 v[92:93], v60 offset:13312
    ds_read_b64_tr_b16 v[94:95], v60 offset:13824
    ds_read_b128 v[48:51], v5 offset:12288
    ds_read_b128 v[52:55], v5 offset:18432
    s_waitcnt lgkmcnt(8)
    v_mfma_f32_16x16x32_bf16 v[16:19], v[84:87], v[32:35], v[16:19]
    v_mfma_f32_16x16x32_bf16 v[20:23], v[84:87], v[36:39], v[20:23]
    ds_read_b64_tr_b16 v[96:97], v60 offset:24576
    ds_read_b64_tr_b16 v[98:99], v60 offset:25088
    ds_read_b128 v[24:27], v4 offset:24576
    ds_read_b128 v[28:31], v4 offset:30720
    s_waitcnt lgkmcnt(8)
    v_mfma_f32_16x16x32_bf16 v[16:19], v[88:91], v[40:43], v[16:19]
    v_mfma_f32_16x16x32_bf16 v[20:23], v[88:91], v[44:47], v[20:23]
    ds_read_b64_tr_b16 v[100:101], v60 offset:25600
    ds_read_b64_tr_b16 v[102:103], v60 offset:26112
    ds_read_b128 v[32:35], v5 offset:24576
    ds_read_b128 v[36:39], v5 offset:30720
    s_waitcnt lgkmcnt(8)
    v_mfma_f32_16x16x32_bf16 v[16:19], v[92:95], v[48:51], v[16:19]
    v_mfma_f32_16x16x32_bf16 v[20:23], v[92:95], v[52:55], v[20:23]
    ds_read_b64_tr_b16 v[104:105], v60 offset:36864
    ds_read_b64_tr_b16 v[106:107], v60 offset:37376
    ds_read_b128 v[40:43], v4 offset:36864
    ds_read_b128 v[44:47], v4 offset:43008
    s_waitcnt lgkmcnt(8)
    v_mfma_f32_16x16x32_bf16 v[16:19], v[96:99], v[24:27], v[16:19]
    v_mfma_f32_16x16x32_bf16 v[20:23], v[96:99], v[28:31], v[20:23]
    ds_read_b64_tr_b16 v[108:109], v60 offset:37888
    ds_read_b64_tr_b16 v[110:111], v60 offset:38400
    ds_read_b128 v[48:51], v5 offset:36864
    ds_read_b128 v[52:55], v5 offset:43008
    s_waitcnt lgkmcnt(8)
    v_mfma_f32_16x16x32_bf16 v[16:19], v[100:103], v[32:35], v[16:19]
    v_mfma_f32_16x16x32_bf16 v[20:23], v[100:103], v[36:39], v[20:23]
    s_waitcnt lgkmcnt(4)
    v_mfma_f32_16x16x32_bf16 v[16:19], v[104:107], v[40:43], v[16:19]
    v_mfma_f32_16x16x32_bf16 v[20:23], v[104:107], v[44:47], v[20:23]
    s_waitcnt lgkmcnt(0)
    v_mfma_f32_16x16x32_bf16 v[16:19], v[108:111], v[48:51], v[16:19]
    v_mfma_f32_16x16x32_bf16 v[20:23], v[108:111], v[52:55], v[20:23]
    ds_read_b64_tr_b16 v[112:113], v61 offset:0
    ds_read_b64_tr_b16 v[114:115], v61 offset:512
    ds_read_b64_tr_b16 v[116:117], v61 offset:1024
    ds_read_b64_tr_b16 v[118:119], v61 offset:1536
    ds_read_b64_tr_b16 v[120:121], v61 offset:12288
    ds_read_b64_tr_b16 v[122:123], v61 offset:12800
    ds_read_b64_tr_b16 v[124:125], v61 offset:13312
    ds_read_b64_tr_b16 v[126:127], v61 offset:13824
    s_waitcnt vmcnt(6)
    s_barrier
    ds_read_b64_tr_b16 v[128:129], v61 offset:24576
    ds_read_b64_tr_b16 v[130:131], v61 offset:25088
    ds_read_b128 v[24:27], v13 offset:0
    ds_read_b128 v[28:31], v13 offset:6144
    ds_read_b64_tr_b16 v[132:133], v61 offset:25600
    ds_read_b64_tr_b16 v[134:135], v61 offset:26112
    ds_read_b128 v[32:35], v14 offset:0
    ds_read_b128 v[36:39], v14 offset:6144
    ds_read_b128 v[40:43], v13 offset:12288
    ds_read_b128 v[44:47], v13 offset:18432
    s_waitcnt lgkmcnt(6)
    v_mfma_f32_16x16x32_bf16 v[16:19], v[112:115], v[24:27], v[16:19]
    v_mfma_f32_16x16x32_bf16 v[20:23], v[112:115], v[28:31], v[20:23]
    ds_read_b128 v[48:51], v14 offset:12288
    ds_read_b128 v[52:55], v14 offset:18432
    s_waitcnt lgkmcnt(4)
    v_mfma_f32_16x16x32_bf16 v[16:19], v[116:119], v[32:35], v[16:19]
    v_mfma_f32_16x16x32_bf16 v[20:23], v[116:119], v[36:39], v[20:23]
    s_waitcnt lgkmcnt(2)
    v_mfma_f32_16x16x32_bf16 v[16:19], v[120:123], v[40:43], v[16:19]
    v_mfma_f32_16x16x32_bf16 v[20:23], v[120:123], v[44:47], v[20:23]
    s_waitcnt lgkmcnt(0)
    v_mfma_f32_16x16x32_bf16 v[16:19], v[124:127], v[48:51], v[16:19]
    v_mfma_f32_16x16x32_bf16 v[20:23], v[124:127], v[52:55], v[20:23]
    s_waitcnt vmcnt(1)
    s_barrier
    v_cmp_ne_u32 vcc, s34, v78
    s_mov_b32 s32, vcc_lo
    ds_read_b128 v[24:27], v13 offset:24576
    ds_read_b128 v[28:31], v13 offset:30720
    ds_read_b128 v[32:35], v14 offset:24576
    ds_read_b128 v[36:39], v14 offset:30720
    ds_read_b64_tr_b16 v[136:137], v61 offset:36864
    ds_read_b64_tr_b16 v[138:139], v61 offset:37376
    ds_read_b128 v[40:43], v13 offset:36864
    ds_read_b128 v[44:47], v13 offset:43008
    s_waitcnt lgkmcnt(6)
    v_mfma_f32_16x16x32_bf16 v[16:19], v[128:131], v[24:27], v[16:19]
    v_mfma_f32_16x16x32_bf16 v[20:23], v[128:131], v[28:31], v[20:23]
    ds_read_b64_tr_b16 v[140:141], v61 offset:37888
    ds_read_b64_tr_b16 v[142:143], v61 offset:38400
    ds_read_b128 v[48:51], v14 offset:36864
    ds_read_b128 v[52:55], v14 offset:43008
    s_waitcnt lgkmcnt(8)
    v_mfma_f32_16x16x32_bf16 v[16:19], v[132:135], v[32:35], v[16:19]
    v_mfma_f32_16x16x32_bf16 v[20:23], v[132:135], v[36:39], v[20:23]
    s_waitcnt lgkmcnt(4)
    v_mfma_f32_16x16x32_bf16 v[16:19], v[136:139], v[40:43], v[16:19]
    v_mfma_f32_16x16x32_bf16 v[20:23], v[136:139], v[44:47], v[20:23]
    s_waitcnt lgkmcnt(0)
    v_mfma_f32_16x16x32_bf16 v[16:19], v[140:143], v[48:51], v[16:19]
    v_mfma_f32_16x16x32_bf16 v[20:23], v[140:143], v[52:55], v[20:23]
L_p1:

    s_cmp_lg_u32 s32, 0
    s_nop 6
    v_swap_b32 v18, v20
    v_swap_b32 v19, v21
    v_bfi_b32 v23, v10, s22, v23
    v_bfi_b32 v19, v10, s22, v19
    s_cbranch_scc1 L_p1slow
    global_store_dwordx4 v77, v[16:19], s[16:17]
    global_store_dwordx4 v77, v[20:23], s[16:17] offset:256
L_p1done:

    s_cmp_ge_u32 s20, 24
    s_cbranch_scc1 L_fin

    s_mov_b32 m0, s92
    s_lshr_b32 s23, s23, 16
    s_barrier
    s_mov_b32 exec_hi, 0x00ffffff
L_ddma:
    global_load_lds_dwordx4 v65, s[10:11] nt
    s_add_u32 m0, m0, 4096
    s_add_u32 s10, s10, s93
    s_addc_u32 s11, s11, 0
    s_sub_u32 s65, s65, 1
    s_cmp_lg_u32 s65, 0
    s_cbranch_scc1 L_ddma
    s_mov_b32 exec_hi, -1
    s_mov_b32 s28, 200000

    s_waitcnt vmcnt(2)
    s_barrier
    ds_read_b64_tr_b16 v[80:81], v66 offset:0
    ds_read_b64_tr_b16 v[82:83], v66 offset:512
    ds_read_b64_tr_b16 v[84:85], v67 offset:0
    ds_read_b64_tr_b16 v[86:87], v67 offset:512
    ds_read_b64_tr_b16 v[88:89], v68 offset:0
    ds_read_b64_tr_b16 v[90:91], v68 offset:512
    ds_read_b64_tr_b16 v[92:93], v69 offset:0
    ds_read_b64_tr_b16 v[94:95], v69 offset:512
    ds_read_b64_tr_b16 v[96:97], v66 offset:8192
    ds_read_b64_tr_b16 v[98:99], v66 offset:8704
    ds_read_b64_tr_b16 v[100:101], v67 offset:8192
    ds_read_b64_tr_b16 v[102:103], v67 offset:8704
    ds_read_b64_tr_b16 v[104:105], v68 offset:8192
    ds_read_b64_tr_b16 v[106:107], v68 offset:8704
    ds_read_b64_tr_b16 v[108:109], v69 offset:8192
    ds_read_b64_tr_b16 v[110:111], v69 offset:8704
    ds_read_b64_tr_b16 v[112:113], v66 offset:16384
    ds_read_b64_tr_b16 v[114:115], v66 offset:16896
    ds_read_b64_tr_b16 v[116:117], v67 offset:16384
    ds_read_b64_tr_b16 v[118:119], v67 offset:16896
    ds_read_b64_tr_b16 v[120:121], v68 offset:16384
    ds_read_b64_tr_b16 v[122:123], v68 offset:16896
    ds_read_b64_tr_b16 v[124:125], v69 offset:16384
    ds_read_b64_tr_b16 v[126:127], v69 offset:16896
    ds_read_b64_tr_b16 v[128:129], v66 offset:24576
    ds_read_b64_tr_b16 v[130:131], v66 offset:25088
    ds_read_b64_tr_b16 v[132:133], v67 offset:24576
    ds_read_b64_tr_b16 v[134:135], v67 offset:25088
    ds_read_b64_tr_b16 v[136:137], v68 offset:24576
    ds_read_b64_tr_b16 v[138:139], v68 offset:25088
    ds_read_b64_tr_b16 v[140:141], v69 offset:24576
    ds_read_b64_tr_b16 v[142:143], v69 offset:25088
    s_waitcnt vmcnt(0)
L_hw:
    global_load_dwordx4 v[176:179], v70, s[16:17] offset:0 sc1
    global_load_dwordx4 v[180:183], v70, s[16:17] offset:2048 sc1
    global_load_dwordx4 v[184:187], v71, s[16:17] offset:0 sc1
    global_load_dwordx4 v[188:191], v71, s[16:17] offset:2048 sc1
    global_load_dwordx4 v[192:195], v72, s[16:17] offset:0 sc1
    global_load_dwordx4 v[196:199], v57, s[16:17] offset:0 sc1
    s_mov_b64 exec, 15
    global_load_dword v216, v63, s[16:17] sc1
    s_mov_b64 exec, -1
    s_waitcnt vmcnt(7)
    s_barrier
    ds_read_b64_tr_b16 v[144:145], v66 offset:32768
    ds_read_b64_tr_b16 v[146:147], v66 offset:33280
    ds_read_b64_tr_b16 v[148:149], v67 offset:32768
    ds_read_b64_tr_b16 v[150:151], v67 offset:33280
    ds_read_b64_tr_b16 v[152:153], v68 offset:32768
    ds_read_b64_tr_b16 v[154:155], v68 offset:33280
    ds_read_b64_tr_b16 v[156:157], v69 offset:32768
    ds_read_b64_tr_b16 v[158:159], v69 offset:33280
    ds_read_b64_tr_b16 v[160:161], v66 offset:40960
    ds_read_b64_tr_b16 v[162:163], v66 offset:41472
    ds_read_b64_tr_b16 v[164:165], v67 offset:40960
    ds_read_b64_tr_b16 v[166:167], v67 offset:41472
    ds_read_b64_tr_b16 v[168:169], v68 offset:40960
    ds_read_b64_tr_b16 v[170:171], v68 offset:41472
    ds_read_b64_tr_b16 v[172:173], v69 offset:40960
    ds_read_b64_tr_b16 v[174:175], v69 offset:41472
    s_waitcnt vmcnt(6) lgkmcnt(15)
    v_cmp_ne_u32_sdwa s[68:69], v179, s23 src0_sel:WORD_1 src1_sel:DWORD
    v_mfma_f32_16x16x32_bf16 v[200:203], v[80:83], v[176:179], 0
    v_mfma_f32_16x16x32_bf16 v[204:207], v[84:87], v[176:179], 0
    v_mfma_f32_16x16x32_bf16 v[208:211], v[88:91], v[176:179], 0
    v_mfma_f32_16x16x32_bf16 v[212:215], v[92:95], v[176:179], 0
    s_waitcnt vmcnt(5) lgkmcnt(15)
    v_cmp_ne_u32_sdwa s[70:71], v183, s23 src0_sel:WORD_1 src1_sel:DWORD
    v_mfma_f32_16x16x32_bf16 v[200:203], v[96:99], v[180:183], v[200:203]
    v_mfma_f32_16x16x32_bf16 v[204:207], v[100:103], v[180:183], v[204:207]
    v_mfma_f32_16x16x32_bf16 v[208:211], v[104:107], v[180:183], v[208:211]
    v_mfma_f32_16x16x32_bf16 v[212:215], v[108:111], v[180:183], v[212:215]
    s_waitcnt vmcnt(4) lgkmcnt(15)
    v_cmp_ne_u32_sdwa s[72:73], v187, s23 src0_sel:WORD_1 src1_sel:DWORD
    v_mfma_f32_16x16x32_bf16 v[200:203], v[112:115], v[184:187], v[200:203]
    v_mfma_f32_16x16x32_bf16 v[204:207], v[116:119], v[184:187], v[204:207]
    v_mfma_f32_16x16x32_bf16 v[208:211], v[120:123], v[184:187], v[208:211]
    v_mfma_f32_16x16x32_bf16 v[212:215], v[124:127], v[184:187], v[212:215]
    s_waitcnt vmcnt(3) lgkmcnt(15)
    v_cmp_ne_u32_sdwa s[74:75], v191, s23 src0_sel:WORD_1 src1_sel:DWORD
    v_mfma_f32_16x16x32_bf16 v[200:203], v[128:131], v[188:191], v[200:203]
    v_mfma_f32_16x16x32_bf16 v[204:207], v[132:135], v[188:191], v[204:207]
    v_mfma_f32_16x16x32_bf16 v[208:211], v[136:139], v[188:191], v[208:211]
    v_mfma_f32_16x16x32_bf16 v[212:215], v[140:143], v[188:191], v[212:215]
    s_waitcnt vmcnt(2) lgkmcnt(8)
    v_cmp_ne_u32_sdwa s[76:77], v195, s23 src0_sel:WORD_1 src1_sel:DWORD
    v_mfma_f32_16x16x32_bf16 v[200:203], v[144:147], v[192:195], v[200:203]
    v_mfma_f32_16x16x32_bf16 v[204:207], v[148:151], v[192:195], v[204:207]
    v_mfma_f32_16x16x32_bf16 v[208:211], v[152:155], v[192:195], v[208:211]
    v_mfma_f32_16x16x32_bf16 v[212:215], v[156:159], v[192:195], v[212:215]
    s_waitcnt vmcnt(1) lgkmcnt(0)
    v_cmp_ne_u32_sdwa s[78:79], v199, s23 src0_sel:WORD_1 src1_sel:DWORD
    s_cmp_le_u32 s67, 5
    s_cbranch_scc1 L_h_mm1
    v_mfma_f32_16x16x32_bf16 v[200:203], v[160:163], v[196:199], v[200:203]
    v_mfma_f32_16x16x32_bf16 v[204:207], v[164:167], v[196:199], v[204:207]
    v_mfma_f32_16x16x32_bf16 v[208:211], v[168:171], v[196:199], v[208:211]
    v_mfma_f32_16x16x32_bf16 v[212:215], v[172:175], v[196:199], v[212:215]
L_h_mm1:
    s_waitcnt vmcnt(0)
    v_cmp_ne_u32_sdwa s[80:81], v216, s23 src0_sel:WORD_1 src1_sel:DWORD
    s_or_b64 vcc, s[68:69], s[70:71]
    s_or_b64 vcc, vcc, s[72:73]
    s_or_b64 vcc, vcc, s[74:75]
    s_or_b64 vcc, vcc, s[76:77]
    s_or_b64 vcc, vcc, s[78:79]
    s_or_b64 vcc, vcc, s[80:81]
    s_cbranch_scc0 L_h_mm_done
L_h_poll:
    s_cmp_lg_u64 s[68:69], 0
    s_cselect_b64 exec, -1, 0
    global_load_dwordx4 v[176:179], v70, s[16:17] offset:0 sc1
    s_cmp_lg_u64 s[70:71], 0
    s_cselect_b64 exec, -1, 0
    global_load_dwordx4 v[180:183], v70, s[16:17] offset:2048 sc1
    s_cmp_lg_u64 s[72:73], 0
    s_cselect_b64 exec, -1, 0
    global_load_dwordx4 v[184:187], v71, s[16:17] offset:0 sc1
    s_cmp_lg_u64 s[74:75], 0
    s_cselect_b64 exec, -1, 0
    global_load_dwordx4 v[188:191], v71, s[16:17] offset:2048 sc1
    s_cmp_lg_u64 s[76:77], 0
    s_cselect_b64 exec, -1, 0
    global_load_dwordx4 v[192:195], v72, s[16:17] offset:0 sc1
    s_cmp_lg_u64 s[78:79], 0
    s_cselect_b64 exec, -1, 0
    global_load_dwordx4 v[196:199], v57, s[16:17] offset:0 sc1
    s_cmp_lg_u64 s[80:81], 0
    s_cselect_b64 exec, 15, 0
    global_load_dword v216, v63, s[16:17] sc1
    s_mov_b64 exec, -1
L_h_chk:
    s_sub_u32 s28, s28, 1
    s_cmp_eq_u32 s28, 0
    s_cbranch_scc1 L_h_go
    s_waitcnt vmcnt(0)
    v_cmp_ne_u32_sdwa s[68:69], v179, s23 src0_sel:WORD_1 src1_sel:DWORD
    v_cmp_ne_u32_sdwa s[70:71], v183, s23 src0_sel:WORD_1 src1_sel:DWORD
    v_cmp_ne_u32_sdwa s[72:73], v187, s23 src0_sel:WORD_1 src1_sel:DWORD
    v_cmp_ne_u32_sdwa s[74:75], v191, s23 src0_sel:WORD_1 src1_sel:DWORD
    v_cmp_ne_u32_sdwa s[76:77], v195, s23 src0_sel:WORD_1 src1_sel:DWORD
    v_cmp_ne_u32_sdwa s[78:79], v199, s23 src0_sel:WORD_1 src1_sel:DWORD
    v_cmp_ne_u32_sdwa s[80:81], v216, s23 src0_sel:WORD_1 src1_sel:DWORD
    s_or_b64 vcc, s[68:69], s[70:71]
    s_or_b64 vcc, vcc, s[72:73]
    s_or_b64 vcc, vcc, s[74:75]
    s_or_b64 vcc, vcc, s[76:77]
    s_or_b64 vcc, vcc, s[78:79]
    s_or_b64 vcc, vcc, s[80:81]
    s_cbranch_scc1 L_h_poll
L_h_go:
    s_waitcnt vmcnt(0)
    v_mfma_f32_16x16x32_bf16 v[200:203], v[80:83], v[176:179], 0
    v_mfma_f32_16x16x32_bf16 v[204:207], v[84:87], v[176:179], 0
    v_mfma_f32_16x16x32_bf16 v[208:211], v[88:91], v[176:179], 0
    v_mfma_f32_16x16x32_bf16 v[212:215], v[92:95], v[176:179], 0
    v_mfma_f32_16x16x32_bf16 v[200:203], v[96:99], v[180:183], v[200:203]
    v_mfma_f32_16x16x32_bf16 v[204:207], v[100:103], v[180:183], v[204:207]
    v_mfma_f32_16x16x32_bf16 v[208:211], v[104:107], v[180:183], v[208:211]
    v_mfma_f32_16x16x32_bf16 v[212:215], v[108:111], v[180:183], v[212:215]
    v_mfma_f32_16x16x32_bf16 v[200:203], v[112:115], v[184:187], v[200:203]
    v_mfma_f32_16x16x32_bf16 v[204:207], v[116:119], v[184:187], v[204:207]
    v_mfma_f32_16x16x32_bf16 v[208:211], v[120:123], v[184:187], v[208:211]
    v_mfma_f32_16x16x32_bf16 v[212:215], v[124:127], v[184:187], v[212:215]
    v_mfma_f32_16x16x32_bf16 v[200:203], v[128:131], v[188:191], v[200:203]
    v_mfma_f32_16x16x32_bf16 v[204:207], v[132:135], v[188:191], v[204:207]
    v_mfma_f32_16x16x32_bf16 v[208:211], v[136:139], v[188:191], v[208:211]
    v_mfma_f32_16x16x32_bf16 v[212:215], v[140:143], v[188:191], v[212:215]
    v_mfma_f32_16x16x32_bf16 v[200:203], v[144:147], v[192:195], v[200:203]
    v_mfma_f32_16x16x32_bf16 v[204:207], v[148:151], v[192:195], v[204:207]
    v_mfma_f32_16x16x32_bf16 v[208:211], v[152:155], v[192:195], v[208:211]
    v_mfma_f32_16x16x32_bf16 v[212:215], v[156:159], v[192:195], v[212:215]
    s_cmp_le_u32 s67, 5
    s_cbranch_scc1 L_h_mm_done
    v_mfma_f32_16x16x32_bf16 v[200:203], v[160:163], v[196:199], v[200:203]
    v_mfma_f32_16x16x32_bf16 v[204:207], v[164:167], v[196:199], v[204:207]
    v_mfma_f32_16x16x32_bf16 v[208:211], v[168:171], v[196:199], v[208:211]
    v_mfma_f32_16x16x32_bf16 v[212:215], v[172:175], v[196:199], v[212:215]
L_h_mm_done:

    s_cmp_eq_u32 s66, 0
    s_cbranch_scc1 L_x0
    s_nop 5
    ds_write_b128 v75, v[200:203]
    ds_write_b128 v75, v[204:207] offset:1024
    s_waitcnt lgkmcnt(0)
    s_barrier
    ds_read_b128 v[200:203], v76
    ds_read_b128 v[204:207], v76 offset:1024
    s_branch L_x1

L_x0:
    s_nop 7
    ds_write_b128 v75, v[208:211]
    ds_write_b128 v75, v[212:215] offset:1024
    s_waitcnt lgkmcnt(0)
    s_barrier
    ds_read_b128 v[208:211], v76
    ds_read_b128 v[212:215], v76 offset:1024
L_x1:
    s_cmp_lg_u32 s32, 0
    s_waitcnt lgkmcnt(0)

    v_pk_add_f32 v[200:201], v[200:201], v[208:209]
    v_pk_add_f32 v[202:203], v[202:203], v[210:211]
    v_pk_add_f32 v[204:205], v[204:205], v[212:213]
    v_pk_add_f32 v[206:207], v[206:207], v[214:215]

    v_bfi_b32 v203, v10, s98, v203
    v_bfi_b32 v207, v10, s98, v207
    s_cbranch_scc1 L_p2slow
    global_store_dwordx4 v74, v[200:203], s[16:17]
    global_store_dwordx4 v74, v[204:207], s[16:17] offset:1024

    s_branch L_stamps
L_p2slow:
    global_store_dwordx4 v74, v[200:203], s[16:17] sc1
    global_store_dwordx4 v74, v[204:207], s[16:17] offset:1024 sc1
    s_branch L_stamps
L_p1slow:
    global_store_dwordx4 v77, v[16:19], s[16:17] sc1
    global_store_dwordx4 v77, v[20:23], s[16:17] offset:256 sc1
    s_branch L_p1done

L_L:

    v_and_b32 v7, 15, v1
    v_lshlrev_b32 v9, 4, v7
    v_and_b32 v5, 31, v1
    v_add_u32 v78, s33, v5
    s_waitcnt lgkmcnt(0)
    s_lshr_b32 s23, s21, 16
    s_add_u32 s23, s23, 1
    s_cmp_gt_u32 s23, 0x7f00
    s_cselect_b32 s23, 1, s23
    s_lshl_b32 s23, s23, 16
    s_add_u32 s22, s21, 1
    s_and_b32 s22, s22, 0xff
    s_max_u32 s22, s22, 1
    s_add_u32 s98, s22, 1
    s_and_b32 s98, s98, 0xff
    s_max_u32 s98, s98, 1
    s_or_b32 s21, s23, s98
    s_lshl_b32 s97, s19, 2
    s_lshr_b32 s97, 0x76543210, s97
    s_and_b32 s97, s97, 7
    v_mov_b32 v10, 0xff
    v_lshl_add_u32 v77, v8, 9, v9
    v_add_u32 v77, s60, v77
    v_bfe_u32 v11, v1, 2, 2
    v_lshlrev_b32 v11, 7, v11
    v_and_b32 v60, 3, v1
    v_lshl_add_u32 v11, v60, 3, v11
    v_bfe_u32 v12, v1, 3, 2
    v_xor_b32 v60, s18, v12
    v_lshl_add_u32 v60, v60, 5, v11
    v_mul_u32_u24 v61, 3072, v8
    v_add_u32 v60, v60, v61
    v_add_u32 v61, 49152, v60
    v_lshrrev_b32 v4, 3, v7
    v_mul_u32_u24 v4, 3072, v4
    v_and_b32 v13, 7, v7
    v_lshl_add_u32 v4, v13, 7, v4
    v_lshrrev_b32 v13, 1, v7
    v_xor_b32 v13, v13, v8
    v_lshl_add_u32 v4, v13, 4, v4
    v_add_u32 v4, 2048, v4
    v_xor_b32 v5, 64, v4
    v_add_u32 v13, 49152, v4
    v_add_u32 v14, 49152, v5

    s_sub_u32 s64, s20, 24
    s_lshl_b32 s65, s64, 1
    s_add_u32 s65, s65, s99
    s_mul_i32 s3, s65, 14
    s_mul_i32 s35, s18, 3
    s_add_u32 s35, s35, s3
    v_add_u32 v64, s35, v8
    s_lshr_b32 s35, s18, 1
    s_add_u32 s35, s35, s3
    s_add_u32 s35, s35, 12
    v_mov_b32 v65, s35
    v_cmp_eq_u32 s[66:67], 3, v8
    s_mul_i32 s3, s19, 458752
    s_add_u32 s3, s3, 4194304
    v_cndmask_b32 v64, v64, v65, s[66:67]
    v_lshrrev_b32 v66, 5, v64
    v_cmp_eq_u32 s[84:85], s24, v66
    v_lshl_add_u32 v64, v64, 8, v9
    s_add_u32 s68, s16, s3
    s_addc_u32 s69, s17, 0

    s_add_u32 s70, s68, 57344
    s_addc_u32 s71, s69, 0
    s_add_u32 s72, s70, 57344
    s_addc_u32 s73, s71, 0
    s_add_u32 s74, s72, 57344
    s_addc_u32 s75, s73, 0
    s_add_u32 s76, s74, 57344
    s_addc_u32 s77, s75, 0
    s_add_u32 s78, s76, 57344
    s_addc_u32 s79, s77, 0
    s_add_u32 s80, s78, 57344
    s_addc_u32 s81, s79, 0
    s_add_u32 s82, s80, 57344
    s_addc_u32 s83, s81, 0
    v_mov_b32 v160, 0
    v_mov_b32 v161, 0
    v_mov_b32 v162, 0
    v_mov_b32 v163, s22
    v_mov_b32 v164, 0
    v_mov_b32 v165, 0
    v_mov_b32 v166, 0
    v_mov_b32 v167, s22
    v_mov_b32 v168, 0
    v_mov_b32 v169, 0
    v_mov_b32 v170, 0
    v_mov_b32 v171, s22
    v_mov_b32 v172, 0
    v_mov_b32 v173, 0
    v_mov_b32 v174, 0
    v_mov_b32 v175, s22

    s_lshl_b32 s3, s19, 14
    s_lshl_b32 s35, s65, 10
    s_add_u32 s3, s3, s35
    s_lshl_b32 s35, s18, 8
    s_add_u32 s3, s3, s35
    s_add_u32 s3, s3, 65536
    v_bfe_u32 v66, v1, 4, 1
    v_lshl_add_u32 v67, v66, 17, v9
    v_lshrrev_b32 v68, 5, v1
    v_add_u32 v67, s3, v67
    s_mov_b32 s35, 0x07060100
    s_bitcmp1_b32 s18, 0
    s_cselect_b32 s35, 0x07060302, s35
    v_mov_b32 v69, 0x03020100
    v_mov_b32 v70, s35
    v_cndmask_b32 v69, v69, v70, s[66:67]
    v_mov_b32 v70, s23
    s_mov_b32 s86, 0xbdd2d3e8
    s_mov_b32 s87, s86
    v_mov_b32 v176, 0xc0135761
    v_mov_b32 v177, v176
    s_bfe_u32 s3, s64, 0x10001
    s_lshl_b32 s35, s19, 3
    s_add_u32 s3, s3, s35
    s_mul_i32 s3, s3, 57344
    s_lshr_b32 s35, s64, 2
    s_lshl_b32 s35, s35, 12
    s_add_u32 s3, s3, s35
    s_and_b32 s35, s65, 3
    s_lshl_b32 s35, s35, 10
    s_add_u32 s3, s3, s35
    s_lshl_b32 s35, s18, 8
    s_add_u32 s3, s3, s35
    s_add_u32 s3, s3, 4194304
    v_mul_u32_u24 v74, 114688, v66
    v_add3_u32 v74, v74, v9, s3

    v_add_u32 v71, 0, v68
    v_cmp_le_u32 vcc, s24, v71
    s_nop 1
    v_addc_co_u32 v71, vcc, 0, v71, vcc
    v_lshl_add_u32 v71, v71, 13, v74
    v_add_u32 v72, 2, v68
    v_cmp_le_u32 vcc, s24, v72
    s_nop 1
    v_addc_co_u32 v72, vcc, 0, v72, vcc
    v_lshl_add_u32 v72, v72, 13, v74
    v_add_u32 v73, 4, v68
    v_cmp_le_u32 vcc, s24, v73
    s_nop 1
    v_addc_co_u32 v73, vcc, 0, v73, vcc
    v_lshl_add_u32 v73, v73, 13, v74

    s_lshr_b32 s3, s64, 2
    s_lshl_b32 s3, s3, 15
    s_lshl_b32 s35, s97, 8
    s_add_u32 s3, s3, s35
    s_and_b32 s35, s65, 7
    s_lshl_b32 s35, s35, 5
    s_add_u32 s3, s3, s35
    s_lshl_b32 s35, s18, 3
    s_add_u32 s3, s3, s35
    v_lshlrev_b32 v74, 11, v7
    v_lshl_add_u32 v74, v8, 1, v74
    v_add_u32 v74, s3, v74

    v_mov_b32 v16, 0
    v_mov_b32 v17, 0
    v_mov_b32 v18, 0
    v_mov_b32 v19, 0
    s_mov_b32 exec_hi, 0
    global_store_dwordx4 v67, v[16:19], s[16:17] sc1
    s_mov_b32 exec_hi, -1
    s_cmp_lg_u32 s99, 0
    s_cbranch_scc1 L_hi
    s_add_u32 m0, s61, 0
    s_nop 0
    global_load_lds_dwordx4 v15, s[4:5] offset:2048
    s_add_u32 m0, s61, 12160
    s_nop 0
    global_load_lds_dwordx4 v15, s[4:5] offset:2176
    s_add_u32 m0, s61, 24320
    s_nop 0
    global_load_lds_dwordx4 v15, s[4:5] offset:2304
    s_add_u32 m0, s61, 36480
    s_nop 0
    global_load_lds_dwordx4 v15, s[4:5] offset:2432
    global_load_ubyte v78, v78, s[14:15] sc1
    s_waitcnt vmcnt(0)
    s_barrier
    v_cmp_ne_u32 vcc, s34, v78
    s_mov_b32 s32, vcc_lo
    ds_read_b64_tr_b16 v[80:81], v60 offset:0
    ds_read_b64_tr_b16 v[82:83], v60 offset:512
    ds_read_b128 v[24:27], v4 offset:0
    ds_read_b128 v[28:31], v4 offset:6144
    ds_read_b64_tr_b16 v[84:85], v60 offset:1024
    ds_read_b64_tr_b16 v[86:87], v60 offset:1536
    ds_read_b128 v[32:35], v5 offset:0
    ds_read_b128 v[36:39], v5 offset:6144
    ds_read_b64_tr_b16 v[88:89], v60 offset:12288
    ds_read_b64_tr_b16 v[90:91], v60 offset:12800
    ds_read_b128 v[40:43], v4 offset:12288
    ds_read_b128 v[44:47], v4 offset:18432
    s_waitcnt lgkmcnt(8)
    v_mfma_f32_16x16x32_bf16 v[16:19], v[80:83], v[24:27], 0
    v_mfma_f32_16x16x32_bf16 v[20:23], v[80:83], v[28:31], 0
    ds_read_b64_tr_b16 v[92:93], v60 offset:13312
    ds_read_b64_tr_b16 v[94:95], v60 offset:13824
    ds_read_b128 v[48:51], v5 offset:12288
    ds_read_b128 v[52:55], v5 offset:18432
    s_waitcnt lgkmcnt(8)
    v_mfma_f32_16x16x32_bf16 v[16:19], v[84:87], v[32:35], v[16:19]
    v_mfma_f32_16x16x32_bf16 v[20:23], v[84:87], v[36:39], v[20:23]
    ds_read_b64_tr_b16 v[96:97], v60 offset:24576
    ds_read_b64_tr_b16 v[98:99], v60 offset:25088
    ds_read_b128 v[24:27], v4 offset:24576
    ds_read_b128 v[28:31], v4 offset:30720
    s_waitcnt lgkmcnt(8)
    v_mfma_f32_16x16x32_bf16 v[16:19], v[88:91], v[40:43], v[16:19]
    v_mfma_f32_16x16x32_bf16 v[20:23], v[88:91], v[44:47], v[20:23]
    ds_read_b64_tr_b16 v[100:101], v60 offset:25600
    ds_read_b64_tr_b16 v[102:103], v60 offset:26112
    ds_read_b128 v[32:35], v5 offset:24576
    ds_read_b128 v[36:39], v5 offset:30720
    s_waitcnt lgkmcnt(8)
    v_mfma_f32_16x16x32_bf16 v[16:19], v[92:95], v[48:51], v[16:19]
    v_mfma_f32_16x16x32_bf16 v[20:23], v[92:95], v[52:55], v[20:23]
    ds_read_b64_tr_b16 v[104:105], v60 offset:36864
    ds_read_b64_tr_b16 v[106:107], v60 offset:37376
    ds_read_b128 v[40:43], v4 offset:36864
    ds_read_b128 v[44:47], v4 offset:43008
    s_waitcnt lgkmcnt(8)
    v_mfma_f32_16x16x32_bf16 v[16:19], v[96:99], v[24:27], v[16:19]
    v_mfma_f32_16x16x32_bf16 v[20:23], v[96:99], v[28:31], v[20:23]
    ds_read_b64_tr_b16 v[108:109], v60 offset:37888
    ds_read_b64_tr_b16 v[110:111], v60 offset:38400
    ds_read_b128 v[48:51], v5 offset:36864
    ds_read_b128 v[52:55], v5 offset:43008
    s_waitcnt lgkmcnt(8)
    v_mfma_f32_16x16x32_bf16 v[16:19], v[100:103], v[32:35], v[16:19]
    v_mfma_f32_16x16x32_bf16 v[20:23], v[100:103], v[36:39], v[20:23]
    s_waitcnt lgkmcnt(4)
    v_mfma_f32_16x16x32_bf16 v[16:19], v[104:107], v[40:43], v[16:19]
    v_mfma_f32_16x16x32_bf16 v[20:23], v[104:107], v[44:47], v[20:23]
    s_waitcnt lgkmcnt(0)
    v_mfma_f32_16x16x32_bf16 v[16:19], v[108:111], v[48:51], v[16:19]
    v_mfma_f32_16x16x32_bf16 v[20:23], v[108:111], v[52:55], v[20:23]
    s_branch L_p1
L_hi:
    s_mov_b32 s32, 0
    s_waitcnt vmcnt(0)
    s_barrier

L_fin:
    s_barrier
    s_mov_b32 s28, 200000
    s_cmp_eq_u64 s[84:85], 0
    s_cbranch_scc1 L_fin_main
    s_mov_b64 exec, s[84:85]

    global_load_dwordx4 v[160:163], v64, s[76:77] sc1
    global_load_dwordx4 v[164:167], v64, s[80:81] sc1
    global_load_dwordx4 v[168:171], v64, s[78:79] sc1
    global_load_dwordx4 v[172:175], v64, s[82:83] sc1
    s_mov_b64 exec, -1
    s_branch L_finx_chk
L_finx_poll:
    s_cmp_lg_u64 s[4:5], 0
    s_cselect_b64 exec, s[84:85], 0
    global_load_dwordx4 v[160:163], v64, s[76:77] sc1
    s_cmp_lg_u64 s[6:7], 0
    s_cselect_b64 exec, s[84:85], 0
    global_load_dwordx4 v[164:167], v64, s[80:81] sc1
    s_cmp_lg_u64 s[8:9], 0
    s_cselect_b64 exec, s[84:85], 0
    global_load_dwordx4 v[168:171], v64, s[78:79] sc1
    s_cmp_lg_u64 s[10:11], 0
    s_cselect_b64 exec, s[84:85], 0
    global_load_dwordx4 v[172:175], v64, s[82:83] sc1
    s_mov_b64 exec, -1
L_finx_chk:
    s_sub_u32 s28, s28, 1
    s_cmp_eq_u32 s28, 0
    s_cbranch_scc1 L_finx_go
    s_waitcnt vmcnt(0)
    v_cmp_ne_u32_sdwa s[4:5], v163, s22 src0_sel:BYTE_0 src1_sel:DWORD
    v_cmp_ne_u32_sdwa s[6:7], v167, s22 src0_sel:BYTE_0 src1_sel:DWORD
    v_cmp_ne_u32_sdwa s[8:9], v171, s22 src0_sel:BYTE_0 src1_sel:DWORD
    v_cmp_ne_u32_sdwa s[10:11], v175, s22 src0_sel:BYTE_0 src1_sel:DWORD
    s_or_b64 vcc, s[4:5], s[6:7]
    s_or_b64 vcc, vcc, s[8:9]
    s_or_b64 vcc, vcc, s[10:11]
    s_cbranch_scc1 L_finx_poll
L_finx_go:
    s_waitcnt vmcnt(0)
L_fin_main:
    s_mov_b32 s28, 200000
    global_load_dwordx4 v[144:147], v64, s[68:69] sc1
    global_load_dwordx4 v[148:151], v64, s[72:73] sc1
    global_load_dwordx4 v[152:155], v64, s[70:71] sc1
    global_load_dwordx4 v[156:159], v64, s[74:75] sc1
    v_and_b32 v163, 0xffffff00, v163
    v_and_b32 v167, 0xffffff00, v167
    v_and_b32 v171, 0xffffff00, v171
    v_and_b32 v175, 0xffffff00, v175
    v_pk_add_f32 v[160:161], v[160:161], v[164:165]
    v_pk_add_f32 v[162:163], v[162:163], v[166:167]
    v_pk_add_f32 v[168:169], v[168:169], v[172:173]
    v_pk_add_f32 v[170:171], v[170:171], v[174:175]
    s_branch L_fin_chk
L_fin_poll:
    s_cmp_lg_u64 s[4:5], 0
    s_cselect_b64 exec, -1, 0
    global_load_dwordx4 v[144:147], v64, s[68:69] sc1
    s_cmp_lg_u64 s[6:7], 0
    s_cselect_b64 exec, -1, 0
    global_load_dwordx4 v[148:151], v64, s[72:73] sc1
    s_cmp_lg_u64 s[8:9], 0
    s_cselect_b64 exec, -1, 0
    global_load_dwordx4 v[152:155], v64, s[70:71] sc1
    s_cmp_lg_u64 s[10:11], 0
    s_cselect_b64 exec, -1, 0
    global_load_dwordx4 v[156:159], v64, s[74:75] sc1
    s_mov_b64 exec, -1
L_fin_chk:
    s_sub_u32 s28, s28, 1
    s_cmp_eq_u32 s28, 0
    s_cbranch_scc1 L_fin_go
    s_waitcnt vmcnt(0)
    v_cmp_ne_u32_sdwa s[4:5], v147, s22 src0_sel:BYTE_0 src1_sel:DWORD
    v_cmp_ne_u32_sdwa s[6:7], v151, s22 src0_sel:BYTE_0 src1_sel:DWORD
    v_cmp_ne_u32_sdwa s[8:9], v155, s22 src0_sel:BYTE_0 src1_sel:DWORD
    v_cmp_ne_u32_sdwa s[10:11], v159, s22 src0_sel:BYTE_0 src1_sel:DWORD
    s_or_b64 vcc, s[4:5], s[6:7]
    s_or_b64 vcc, vcc, s[8:9]
    s_or_b64 vcc, vcc, s[10:11]
    s_cbranch_scc1 L_fin_poll
L_fin_go:
    s_waitcnt vmcnt(0)
    v_xor_b32 v147, s22, v147
    v_xor_b32 v151, s22, v151
    v_xor_b32 v155, s22, v155
    v_xor_b32 v159, s22, v159
    v_pk_add_f32 v[144:145], v[144:145], v[148:149]
    v_pk_add_f32 v[146:147], v[146:147], v[150:151]
    v_pk_add_f32 v[152:153], v[152:153], v[156:157]
    v_pk_add_f32 v[154:155], v[154:155], v[158:159]
    v_pk_add_f32 v[144:145], v[144:145], v[160:161]
    v_pk_add_f32 v[146:147], v[146:147], v[162:163]
    v_pk_add_f32 v[152:153], v[152:153], v[168:169]
    v_pk_add_f32 v[154:155], v[154:155], v[170:171]
    v_cvt_pk_bf16_f32 v36, v144, v145
    v_cvt_pk_bf16_f32 v37, v146, v147
    v_cvt_pk_bf16_f32 v38, v152, v153
    v_cvt_pk_bf16_f32 v39, v154, v155
    v_lshlrev_b32 v24, 16, v36
    v_and_b32 v25, 0xffff0000, v36
    v_lshlrev_b32 v26, 16, v37
    v_and_b32 v27, 0xffff0000, v37
    v_pk_mul_f32 v[32:33], v[24:25], v[24:25]
    v_pk_mul_f32 v[34:35], v[26:27], v[26:27]
    v_pk_fma_f32 v[32:33], v[32:33], s[86:87], v[176:177]
    v_pk_fma_f32 v[34:35], v[34:35], s[86:87], v[176:177]
    v_pk_mul_f32 v[32:33], v[32:33], v[24:25]
    v_pk_mul_f32 v[34:35], v[34:35], v[26:27]
    v_exp_f32 v32, v32
    v_exp_f32 v33, v33
    v_exp_f32 v34, v34
    v_exp_f32 v35, v35
    v_lshlrev_b32 v28, 16, v38
    v_and_b32 v29, 0xffff0000, v38
    v_lshlrev_b32 v30, 16, v39
    v_and_b32 v31, 0xffff0000, v39
    v_pk_add_f32 v[32:33], v[32:33], 1.0 op_sel_hi:[1,0]
    v_pk_add_f32 v[34:35], v[34:35], 1.0 op_sel_hi:[1,0]
    v_rcp_f32 v32, v32
    v_rcp_f32 v33, v33
    v_rcp_f32 v34, v34
    v_rcp_f32 v35, v35
    v_pk_mul_f32 v[32:33], v[32:33], v[24:25]
    v_pk_mul_f32 v[34:35], v[34:35], v[26:27]
    v_cvt_pk_bf16_f32 v36, v32, v33
    v_cvt_pk_bf16_f32 v37, v34, v35
    v_lshlrev_b32 v32, 16, v36
    v_and_b32 v33, 0xffff0000, v36
    v_lshlrev_b32 v34, 16, v37
    v_and_b32 v35, 0xffff0000, v37
    v_pk_mul_f32 v[32:33], v[32:33], v[28:29]
    v_pk_mul_f32 v[34:35], v[34:35], v[30:31]
    v_cvt_pk_bf16_f32 v36, v32, v33
    v_cvt_pk_bf16_f32 v37, v34, v35
    v_perm_b32 v36, v70, v36, v69
    v_perm_b32 v37, v70, v37, v69

    s_nop 1
    v_permlane16_swap_b32 v36, v37
    s_nop 1
    v_permlane32_swap_b32 v36, v38
    v_permlane32_swap_b32 v37, v39
    s_mov_b32 exec_hi, 0
    s_barrier
    global_store_dwordx4 v67, v[36:39], s[16:17] sc1
    s_mov_b32 exec_hi, -1

    s_mov_b32 s28, 200000
    global_load_dwordx4 v[80:83], v71, s[16:17] sc1
    global_load_dwordx4 v[84:87], v72, s[16:17] sc1
    global_load_dwordx4 v[88:91], v73, s[16:17] sc1
    s_branch L_red_chk
L_red_poll:
    s_cmp_lg_u64 s[4:5], 0
    s_cselect_b64 exec, -1, 0
    global_load_dwordx4 v[80:83], v71, s[16:17] sc1
    s_cmp_lg_u64 s[6:7], 0
    s_cselect_b64 exec, -1, 0
    global_load_dwordx4 v[84:87], v72, s[16:17] sc1
    s_cmp_lg_u64 s[8:9], 0
    s_cselect_b64 exec, -1, 0
    global_load_dwordx4 v[88:91], v73, s[16:17] sc1
    s_mov_b64 exec, -1
L_red_chk:
    s_sub_u32 s28, s28, 1
    s_cmp_eq_u32 s28, 0
    s_cbranch_scc1 L_red_go
    s_waitcnt vmcnt(0)
    v_cmp_ne_u32_sdwa s[4:5], v83, s98 src0_sel:BYTE_0 src1_sel:DWORD
    v_cmp_ne_u32_sdwa s[6:7], v87, s98 src0_sel:BYTE_0 src1_sel:DWORD
    v_cmp_ne_u32_sdwa s[8:9], v91, s98 src0_sel:BYTE_0 src1_sel:DWORD
    s_or_b64 vcc, s[4:5], s[6:7]
    s_or_b64 vcc, vcc, s[8:9]
    s_cbranch_scc1 L_red_poll
L_red_go:
    s_waitcnt vmcnt(0)
    v_xor_b32 v83, s98, v83
    v_xor_b32 v87, s98, v87
    v_xor_b32 v91, s98, v91
    v_pk_add_f32 v[80:81], v[80:81], v[84:85]
    v_pk_add_f32 v[82:83], v[82:83], v[86:87]
    v_pk_add_f32 v[80:81], v[80:81], v[88:89]
    v_pk_add_f32 v[82:83], v[82:83], v[90:91]

    s_nop 1
    v_permlane32_swap_b32 v80, v82
    v_permlane32_swap_b32 v81, v83
    s_nop 0
    v_pk_add_f32 v[80:81], v[80:81], v[82:83]
    s_mov_b32 s4, 0xffff
    s_mov_b32 s5, s4
    v_permlane16_swap_b32 v80, v82
    v_permlane16_swap_b32 v81, v83
    s_mov_b64 exec, s[4:5]
    v_pk_add_f32 v[80:81], v[80:81], v[82:83]
    v_cvt_pk_bf16_f32 v80, v80, v81
    global_store_dword v74, v80, s[12:13]
    s_mov_b64 exec, -1
    s_cmp_lg_u32 s2, 192
    s_cbranch_scc1 L_stamps
    s_add_u32 s3, s18, s99
    s_cmp_lg_u32 s3, 0
    s_cbranch_scc1 L_stamps
    v_mov_b32 v33, 12
    v_mov_b32 v34, s21
    s_mov_b64 exec, 1
    global_store_dword v33, v34, s[16:17]
    s_mov_b64 exec, -1

L_stamps:
L_end:
    s_endpgm
    .fill 512, 4, 0xBF800000
.section .rodata,"a"
.p2align 6
.amdhsa_kernel standalone__glu_gated_geglu__sampling_kernel
  .amdhsa_next_free_vgpr 224
  .amdhsa_next_free_sgpr 102
  .amdhsa_accum_offset 224
  .amdhsa_group_segment_fixed_size 0
  .amdhsa_kernarg_size 56
  .amdhsa_user_sgpr_count 2
  .amdhsa_user_sgpr_kernarg_segment_ptr 1
  .amdhsa_system_sgpr_workgroup_id_x 1
.end_amdhsa_kernel
```
